```python
import torch

def _softmax(x, axis=-1):
    return torch.softmax(x, dim=axis)
def _gelu(x):
    return torch.nn.functional.gelu(x, approximate="tanh")
def _silu(x):
    return torch.nn.functional.silu(x)
def _sigmoid(x):
    return torch.sigmoid(x)
def _layernorm(x, axis=-1, eps=1e-5):
    m = x.mean(dim=axis, keepdim=True)
    v = x.var(dim=axis, keepdim=True, unbiased=False)
    return (x - m) / torch.sqrt(v + eps)
def _scatter_add(tgt, idx, src, axis=0):
    return tgt.clone().index_add_(axis, idx, src)
def _segment_sum(src, seg, n):
    out = torch.zeros((n,) + src.shape[1:], dtype=src.dtype)
    return out.index_add_(0, seg, src)
def _pad(x, pw):
    flat = tuple(v for pair in reversed(pw) for v in pair)
    return torch.nn.functional.pad(x, flat)

kernel_name = 'recurrent_scan__sliding_block_cached__glu_gated_reglu__decode'

def setup_inputs():

    _w = (lambda a: (lambda t: t.to(torch.bfloat16) if t.is_floating_point() else t)(torch.as_tensor(a)))
    def _A_setup():
        B, Sq, D = 1, 1, 448
        Hq, Hkv, Sk, Dh = 16, 8, 65536, 256
        assert Hq % Hkv == 0, (Hq, Hkv)
        return {
            "x": _w((lambda *s: torch.randn(*s, dtype=torch.bfloat16) * 0.2)(B, Sq, D)),
            "k_cache": _w((lambda *s: torch.randn(*s, dtype=torch.bfloat16) * 1.6)(B, Hkv, Sk, Dh)),
            "v_cache": _w((lambda *s: torch.randn(*s, dtype=torch.bfloat16) * 1.6)(B, Hkv, Sk, Dh)),
            "wq": _w((lambda *s: torch.randn(*s, dtype=torch.bfloat16) * 1.6)(D, Hq * Dh) * (D ** -0.5)),
            "wo": _w((lambda *s: torch.randn(*s, dtype=torch.bfloat16) * 1.6)(Hq * Dh, D) * ((Hq * Dh) ** -0.5)),
        }
    _A_in = _A_setup()

    def _B_setup():
        B, S, D, F = 1, 1, 448, 1792
        return {
            "x": _w((lambda *s: torch.randn(*s, dtype=torch.bfloat16) * 0.2)(B, S, D)),
            "W_gate": _w((lambda *s: torch.randn(*s, dtype=torch.bfloat16) * 0.8)(D, F) * (2.0 / D) ** 0.5),
            "W_up": _w((lambda *s: torch.randn(*s, dtype=torch.bfloat16) * 0.8)(D, F) * (2.0 / D) ** 0.5),
            "W_down": _w((lambda *s: torch.randn(*s, dtype=torch.bfloat16) * 0.8)(F, D) * (1.0 / F) ** 0.5),
        }
    _B_in = _B_setup()

    return {
        "A_x": _A_in["x"],
        "A_k_cache": _A_in["k_cache"],
        "A_v_cache": _A_in["v_cache"],
        "A_wq": _A_in["wq"],
        "A_wo": _A_in["wo"],
        "B_x": _B_in["x"],
        "B_W_gate": _B_in["W_gate"],
        "B_W_up": _B_in["W_up"],
        "B_W_down": _B_in["W_down"],
    }

def reference(A_x, A_k_cache, A_v_cache, A_wq, A_wo, B_x, B_W_gate, B_W_up, B_W_down):
    def _A_ref(x, k_cache, v_cache, wq, wo):
        B, Sq, D = x.shape
        Hq, Dh = 16, 256
        Hkv, Sk = k_cache.shape[1], k_cache.shape[2]
        W = min(4096, max(256, Sk // 4))
        rep = Hq // Hkv
        q = (lambda x, *d: x.permute(*d))((x @ wq).reshape(B, Sq, Hq, Dh), 0, 2, 1, 3)
        k = (lambda x, n, axis: torch.repeat_interleave(x, n, dim=axis))(k_cache[:, :, Sk - W:, :], rep, axis=1)
        v = (lambda x, n, axis: torch.repeat_interleave(x, n, dim=axis))(v_cache[:, :, Sk - W:, :], rep, axis=1)
        scores = torch.einsum("bhqd,bhkd->bhqk", q, k) * (Dh ** -0.5)
        p = _softmax(scores, axis=-1)
        o = torch.einsum("bhqk,bhkd->bhqd", p, v)
        return (lambda x, *d: x.permute(*d))(o, 0, 2, 1, 3).reshape(B, Sq, Hq * Dh) @ wo

    def _B_ref(x, W_gate, W_up, W_down):
        gate = torch.einsum("bsd,df->bsf", x, W_gate)
        up = torch.einsum("bsd,df->bsf", x, W_up)
        gate = gate * (lambda x, dt: x.to(dt))(gate > 0, gate.dtype)
        h = gate * up
        return torch.einsum("bsf,fd->bsd", h, W_down)

    x = A_x
    xn = _layernorm(x, axis=-1)
    s = _A_ref(xn, A_k_cache, A_v_cache, A_wq, A_wo)
    g = _silu(_B_ref(xn, B_W_gate, B_W_up, B_W_down))
    return x + s * g
```

```asm
; @launch grid=(256,1,1) block=(768,1,1) lds=8192
.amdgcn_target "amdgcn-amd-amdhsa--gfx950"
.text
.p2align 12
.globl recurrent_scan__sliding_block_cached__glu_gated_reglu__decode_kernel
.p2align 8
.type recurrent_scan__sliding_block_cached__glu_gated_reglu__decode_kernel,@function
recurrent_scan__sliding_block_cached__glu_gated_reglu__decode_kernel:
    s_load_dwordx16 s[16:31], s[0:1], 0
    s_load_dwordx8 s[32:39], s[0:1], 64
    v_lshrrev_b32 v2, 6, v0
    s_cmp_ge_u32 s2, 256
    s_cbranch_scc1 L_end
    v_readfirstlane_b32 s4, v2
    v_and_b32 v1, 63, v0
    s_and_b32 s5, s2, 7
    s_lshr_b32 s6, s2, 3
    s_cmp_ge_u32 s4, 4
    s_cbranch_scc1 L_A
    s_lshl3_add_u32 s10, s4, 32
    s_cmp_lt_u32 s4, 2
    s_cselect_b32 s10, 24, s10
    s_load_dwordx2 s[40:41], s[0:1], s10
    s_setprio 3
    v_mov_b32 v125, 0
    s_mov_b32 s13, 0x05040100
    s_mov_b32 s14, 0x07060302
    s_mov_b32 s12, 0xffffff00
    s_mov_b32 s15, 0xffff0000
    v_lshrrev_b32 v2, 3, v1
    v_min_u32 v2, 6, v2
    v_and_b32 v3, 7, v1
    v_lshlrev_b32 v7, 3, v3
    v_mov_b32 v124, 0
    ds_write_b64 v7, v[124:125] offset:5312
    s_lshr_b32 s45, s6, 3
    s_lshl1_add_u32 s42, s45, s4
    s_and_b32 s43, s6, 7
    s_lshl3_add_u32 s44, s5, s43
    s_lshl2_add_u32 s45, s5, s45
    s_movk_i32 s46, 3584
    s_lshl2_add_u32 s54, s6, s4
    s_cmp_lt_u32 s4, 2
    s_cselect_b32 s42, s42, s43
    s_cselect_b32 s44, s44, s45
    s_cselect_b32 s46, 8192, s46
    s_cselect_b32 s3, 0, s5
    s_mul_i32 s42, s42, 56
    s_mul_i32 s47, s42, s46
    s_lshl_b32 s44, s44, 7
    s_add_u32 s47, s47, s44
    s_lshl_b32 s43, s46, 3
    v_mul_u32_u24 v4, s43, v2
    v_lshl_add_u32 v4, v3, 4, v4
    v_add_u32 v4, s47, v4
    s_lshl_b32 s42, s42, 1
    v_lshl_add_u32 v5, v2, 4, s42
    v_min_u32 v6, 55, v1
    v_lshlrev_b32 v6, 4, v6
    v_lshlrev_b32 v7, 4, v0
    v_mov_b32 v116, 0
    s_cmp_lt_u32 s4, 2
    s_cbranch_scc1 L_g_go
    s_waitcnt lgkmcnt(0)
    s_barrier
    s_cmp_eq_u32 s3, 7
    s_cbranch_scc1 L_g_noload
L_g_go:
    s_waitcnt lgkmcnt(0)
    global_load_dwordx4 v[8:11], v6, s[16:17]
    global_load_dwordx4 v[12:15], v5, s[16:17]
    global_load_dwordx4 v[16:19], v4, s[40:41] nt
    v_add_u32 v4, s46, v4
    global_load_dwordx4 v[20:23], v4, s[40:41] nt
    v_add_u32 v4, s46, v4
    global_load_dwordx4 v[24:27], v4, s[40:41] nt
    v_add_u32 v4, s46, v4
    global_load_dwordx4 v[28:31], v4, s[40:41] nt
    v_add_u32 v4, s46, v4
    global_load_dwordx4 v[32:35], v4, s[40:41] nt
    v_add_u32 v4, s46, v4
    global_load_dwordx4 v[36:39], v4, s[40:41] nt
    v_add_u32 v4, s46, v4
    global_load_dwordx4 v[40:43], v4, s[40:41] nt
    v_add_u32 v4, s46, v4
    global_load_dwordx4 v[44:47], v4, s[40:41] nt
L_g_noload:
    s_barrier
    s_load_dword s50, s[38:39], 0
    s_cmp_ge_u32 s4, 2
    s_cbranch_scc1 L_g_nob0b
    s_cmp_lg_u32 s54, 113
    s_cbranch_scc1 L_noinit
    s_mul_i32 s11, s5, 6144
    s_add_u32 s11, s11, 1048576
    v_lshrrev_b32 v120, 2, v1
    v_mul_u32_u24 v120, 384, v120
    v_and_b32 v121, 3, v1
    v_lshlrev_b32 v121, 4, v121
    v_add3_u32 v120, v120, v121, s11
    v_mov_b64 v[122:123], 0
    v_mov_b32 v124, 0
    global_store_dwordx4 v120, v[122:125], s[38:39] sc1
L_noinit:
    s_barrier
L_g_nob0b:
    s_cmp_eq_u32 s3, 7
    s_cbranch_scc1 L_w_prep
    v_mov_b64 v[48:49], 0
    v_mov_b64 v[50:51], 0
    v_mov_b64 v[52:53], 0
    v_mov_b64 v[54:55], 0
    v_mov_b64 v[56:57], 0
    v_mov_b64 v[58:59], 0
    v_mov_b64 v[60:61], 0
    v_mov_b64 v[62:63], 0
    v_mov_b64 v[64:65], 0
    v_mov_b64 v[66:67], 0
    v_mov_b64 v[68:69], 0
    v_mov_b64 v[70:71], 0
    v_mov_b64 v[72:73], 0
    v_mov_b64 v[74:75], 0
    v_mov_b64 v[76:77], 0
    v_mov_b64 v[78:79], 0
    v_cmp_gt_u32 vcc, 56, v1
    s_mov_b32 s48, 0x01010101
    s_mov_b32 s49, 0x00010101
    s_waitcnt vmcnt(9)
    v_lshlrev_b32 v116, 16, v8
    v_and_b32 v117, s15, v8
    v_lshlrev_b32 v118, 16, v9
    v_and_b32 v119, s15, v9
    v_lshlrev_b32 v120, 16, v10
    v_and_b32 v121, s15, v10
    v_lshlrev_b32 v122, 16, v11
    v_and_b32 v123, s15, v11
    v_pk_add_f32 v[8:9], v[116:117], v[118:119]
    v_pk_add_f32 v[10:11], v[120:121], v[122:123]
    v_pk_add_f32 v[8:9], v[8:9], v[10:11]
    v_add_f32 v8, v8, v9
    v_cndmask_b32 v8, 0, v8, vcc
    s_nop 1
    v_add_f32_dpp v8, v8, v8 row_ror:1 row_mask:0xf bank_mask:0xf
    s_nop 1
    v_add_f32_dpp v8, v8, v8 row_ror:2 row_mask:0xf bank_mask:0xf
    s_nop 1
    v_add_f32_dpp v8, v8, v8 row_ror:4 row_mask:0xf bank_mask:0xf
    s_nop 1
    v_add_f32_dpp v8, v8, v8 row_ror:8 row_mask:0xf bank_mask:0xf
    v_mov_b32 v9, v8
    s_nop 1
    v_permlane16_swap_b32 v8, v9
    v_add_f32 v8, v8, v9
    v_mov_b32 v9, v8
    s_nop 1
    v_permlane32_swap_b32 v8, v9
    v_add_f32 v8, v8, v9
    v_mul_f32 v8, 0x3b124925, v8
    v_sub_f32 v116, v116, v8
    v_sub_f32 v117, v117, v8
    v_sub_f32 v118, v118, v8
    v_sub_f32 v119, v119, v8
    v_sub_f32 v120, v120, v8
    v_sub_f32 v121, v121, v8
    v_sub_f32 v122, v122, v8
    v_sub_f32 v123, v123, v8
    v_mul_f32 v10, v116, v116
    v_mul_f32 v11, v117, v117
    v_fmac_f32 v10, v118, v118
    v_fmac_f32 v11, v119, v119
    v_fmac_f32 v10, v120, v120
    v_fmac_f32 v11, v121, v121
    v_fmac_f32 v10, v122, v122
    v_fmac_f32 v11, v123, v123
    v_add_f32 v10, v10, v11
    v_cndmask_b32 v10, 0, v10, vcc
    v_cvt_pk_bf16_f32 v8, 0, v8
    s_waitcnt vmcnt(8)
    v_add_f32_dpp v10, v10, v10 row_ror:1 row_mask:0xf bank_mask:0xf
    v_lshlrev_b32 v116, 16, v12
    v_and_b32 v117, s15, v12
    v_add_f32_dpp v10, v10, v10 row_ror:2 row_mask:0xf bank_mask:0xf
    v_lshlrev_b32 v118, 16, v13
    v_and_b32 v119, s15, v13
    v_add_f32_dpp v10, v10, v10 row_ror:4 row_mask:0xf bank_mask:0xf
    v_lshlrev_b32 v120, 16, v14
    v_and_b32 v121, s15, v14
    v_add_f32_dpp v10, v10, v10 row_ror:8 row_mask:0xf bank_mask:0xf
    v_lshlrev_b32 v122, 16, v15
    v_and_b32 v123, s15, v15
    v_mov_b32 v11, v10
    v_sub_f32 v116, v116, v8
    v_sub_f32 v117, v117, v8
    v_permlane16_swap_b32 v10, v11
    v_add_f32 v10, v10, v11
    v_mov_b32 v11, v10
    v_sub_f32 v118, v118, v8
    v_sub_f32 v119, v119, v8
    v_permlane32_swap_b32 v10, v11
    v_add_f32 v10, v10, v11
    v_mul_f32 v10, 0x3b124925, v10
    v_sub_f32 v120, v120, v8
    v_cvt_pk_bf16_f32 v10, 0, v10
    v_sub_f32 v121, v121, v8
    v_add_f32 v10, 0x3727c5ac, v10
    v_sub_f32 v122, v122, v8
    v_cvt_pk_bf16_f32 v10, 0, v10
    v_sub_f32 v123, v123, v8
    v_sqrt_f32 v10, v10
    v_cvt_pk_bf16_f32 v116, 0, v116
    v_cvt_pk_bf16_f32 v117, 0, v117
    v_cvt_pk_bf16_f32 v118, 0, v118
    v_cvt_pk_bf16_f32 v10, 0, v10
    v_cvt_pk_bf16_f32 v119, 0, v119
    v_rcp_f32 v10, v10
    v_cvt_pk_bf16_f32 v120, 0, v120
    v_cvt_pk_bf16_f32 v121, 0, v121
    v_cvt_pk_bf16_f32 v122, 0, v122
    v_cvt_pk_bf16_f32 v123, 0, v123
    v_mul_f32 v116, v116, v10
    v_mul_f32 v117, v117, v10
    v_mul_f32 v118, v118, v10
    v_mul_f32 v119, v119, v10
    v_mul_f32 v120, v120, v10
    v_mul_f32 v121, v121, v10
    v_mul_f32 v122, v122, v10
    v_mul_f32 v123, v123, v10
    v_cvt_pk_bf16_f32 v12, v116, v117
    v_cvt_pk_bf16_f32 v13, v118, v119
    v_cvt_pk_bf16_f32 v14, v120, v121
    v_cvt_pk_bf16_f32 v15, v122, v123
    s_lshl_b64 exec, s[48:49], 0
    v_mov_b64 v[48:49], v[12:13]
    v_mov_b64 v[50:51], v[14:15]
    s_lshl_b64 exec, s[48:49], 1
    v_mov_b64 v[52:53], v[12:13]
    v_mov_b64 v[54:55], v[14:15]
    s_lshl_b64 exec, s[48:49], 2
    v_mov_b64 v[56:57], v[12:13]
    v_mov_b64 v[58:59], v[14:15]
    s_lshl_b64 exec, s[48:49], 3
    v_mov_b64 v[60:61], v[12:13]
    v_mov_b64 v[62:63], v[14:15]
    s_lshl_b64 exec, s[48:49], 4
    v_mov_b64 v[64:65], v[12:13]
    v_mov_b64 v[66:67], v[14:15]
    s_lshl_b64 exec, s[48:49], 5
    v_mov_b64 v[68:69], v[12:13]
    v_mov_b64 v[70:71], v[14:15]
    s_lshl_b64 exec, s[48:49], 6
    v_mov_b64 v[72:73], v[12:13]
    v_mov_b64 v[74:75], v[14:15]
    s_lshl_b64 exec, s[48:49], 7
    v_mov_b64 v[76:77], v[12:13]
    v_mov_b64 v[78:79], v[14:15]
    s_mov_b64 exec, -1
    s_waitcnt vmcnt(6)
    v_perm_b32 v80, v20, v16, s13
    v_perm_b32 v84, v20, v16, s14
    v_perm_b32 v88, v21, v17, s13
    v_perm_b32 v92, v21, v17, s14
    v_perm_b32 v96, v22, v18, s13
    v_perm_b32 v100, v22, v18, s14
    v_perm_b32 v104, v23, v19, s13
    v_perm_b32 v108, v23, v19, s14
    s_waitcnt vmcnt(4)
    v_perm_b32 v81, v28, v24, s13
    v_perm_b32 v85, v28, v24, s14
    v_perm_b32 v89, v29, v25, s13
    v_perm_b32 v93, v29, v25, s14
    v_perm_b32 v97, v30, v26, s13
    v_perm_b32 v101, v30, v26, s14
    v_perm_b32 v105, v31, v27, s13
    v_perm_b32 v109, v31, v27, s14
    s_waitcnt vmcnt(2)
    v_perm_b32 v82, v36, v32, s13
    v_perm_b32 v86, v36, v32, s14
    v_perm_b32 v90, v37, v33, s13
    v_perm_b32 v94, v37, v33, s14
    v_perm_b32 v98, v38, v34, s13
    v_perm_b32 v102, v38, v34, s14
    v_perm_b32 v106, v39, v35, s13
    v_perm_b32 v110, v39, v35, s14
    s_waitcnt vmcnt(0)
    v_perm_b32 v83, v44, v40, s13
    v_perm_b32 v87, v44, v40, s14
    v_perm_b32 v91, v45, v41, s13
    v_perm_b32 v95, v45, v41, s14
    v_perm_b32 v99, v46, v42, s13
    v_perm_b32 v103, v46, v42, s14
    v_perm_b32 v107, v47, v43, s13
    v_perm_b32 v111, v47, v43, s14
    v_mfma_f32_16x16x32_bf16 v[112:115], v[48:51], v[80:83], 0
    v_mfma_f32_16x16x32_bf16 v[112:115], v[52:55], v[84:87], v[112:115]
    v_mfma_f32_16x16x32_bf16 v[112:115], v[56:59], v[88:91], v[112:115]
    v_mfma_f32_16x16x32_bf16 v[112:115], v[60:63], v[92:95], v[112:115]
    v_mfma_f32_16x16x32_bf16 v[112:115], v[64:67], v[96:99], v[112:115]
    v_mfma_f32_16x16x32_bf16 v[112:115], v[68:71], v[100:103], v[112:115]
    v_mfma_f32_16x16x32_bf16 v[112:115], v[72:75], v[104:107], v[112:115]
    v_mfma_f32_16x16x32_bf16 v[112:115], v[76:79], v[108:111], v[112:115]
    s_waitcnt lgkmcnt(0)
    s_add_u32 s9, s50, 0x5b
    s_and_b32 s9, s9, 0xff
    v_mov_b32 v6, s9
    s_cmp_lt_u32 s4, 2
    s_cbranch_scc1 L_g_q
    v_lshrrev_b32 v2, 1, v3
    v_lshlrev_b32 v2, 7, v2
    v_and_b32 v4, 1, v3
    v_lshl_add_u32 v2, v4, 5, v2
    v_and_b32 v4, 16, v1
    s_lshl_b32 s42, s5, 14
    s_lshl_b32 s43, s6, 9
    s_add_u32 s42, s42, s43
    s_lshl_b32 s43, s4, 6
    s_add_u32 s42, s42, s43
    s_add_u32 s42, s42, 130944
    v_add3_u32 v116, v2, v4, s42
    v_mov_b32 v8, v112
    v_mov_b32 v9, v113
    v_mov_b32 v10, v114
    v_mov_b32 v11, v115
    v_permlane32_swap_b32 v112, v8
    v_permlane32_swap_b32 v113, v9
    v_permlane32_swap_b32 v114, v10
    v_permlane32_swap_b32 v115, v11
    v_add_f32_dpp v112, v8, v112 row_ror:8 row_mask:0xf bank_mask:0xf
    v_add_f32_dpp v113, v9, v113 row_ror:8 row_mask:0xf bank_mask:0xf
    v_add_f32_dpp v114, v10, v114 row_ror:8 row_mask:0xf bank_mask:0xf
    v_add_f32_dpp v115, v11, v115 row_ror:8 row_mask:0xf bank_mask:0xf
    v_bfi_b32 v112, s12, v112, v6
    v_bfi_b32 v113, s12, v113, v6
    v_bfi_b32 v114, s12, v114, v6
    v_bfi_b32 v115, s12, v115, v6
    s_mov_b64 exec, 0x00ff00ff
    global_store_dwordx4 v116, v[112:115], s[38:39]
    s_mov_b64 exec, -1
    s_branch L_w_prep
L_g_q:
    s_getreg_b32 s11, hwreg(HW_REG_XCC_ID, 0, 4)
    v_lshrrev_b32 v4, 1, v1
    v_and_b32 v5, 1, v1
    v_lshl_add_u32 v4, v5, 4, v4
    v_lshlrev_b32 v4, 4, v4
    s_lshl_b32 s42, s5, 13
    s_add_u32 s42, s42, 4096
    v_mov_b32 v11, 1
    ds_write_b128 v7, v[112:115] offset:0
    s_cmp_eq_u32 s4, 0
    s_cbranch_scc1 L_q_pub
    ds_write_b32 v125, v11 offset:5320
    s_cmp_lg_u32 s54, 113
    s_cbranch_scc1 L_w_prep
    s_mul_i32 s11, s9, 0x01010101
    v_mov_b32 v11, s11
    s_lshl_b32 s11, s5, 7
    s_add_u32 s11, s11, 917504
    v_mov_b32 v10, s11
    s_mov_b64 exec, 1
    global_store_dword v10, v11, s[38:39] sc1
    s_mov_b64 exec, -1
    s_branch L_w_prep
L_q_pub:
    s_mov_b64 exec, 0xffff
    ds_read_b128 v[16:19], v4 offset:0
    ds_read_b128 v[20:23], v4 offset:640
    s_lshl_b32 s43, s6, 8
    s_add_u32 s43, s43, s42
    v_add_u32 v9, s43, v7
    v_xor_b32 v10, s11, v6
L_q_spin:
    ds_read_b32 v8, v125 offset:5320
    ds_read_b128 v[24:27], v4 offset:1024
    ds_read_b128 v[28:31], v4 offset:1664
    s_waitcnt lgkmcnt(2)
    v_cmp_eq_u32 vcc, 0, v8
    s_waitcnt lgkmcnt(0)
    s_cbranch_vccnz L_q_spin
    v_pk_add_f32 v[16:17], v[16:17], v[20:21]
    v_pk_add_f32 v[18:19], v[18:19], v[22:23]
    v_pk_add_f32 v[24:25], v[24:25], v[28:29]
    v_pk_add_f32 v[26:27], v[26:27], v[30:31]
    v_pk_add_f32 v[16:17], v[16:17], v[24:25]
    v_pk_add_f32 v[18:19], v[18:19], v[26:27]
    v_bfi_b32 v16, s12, v16, v6
    v_bfi_b32 v17, s12, v17, v6
    v_bfi_b32 v18, s12, v18, v6
    v_bfi_b32 v19, s12, v19, v10
    global_store_dwordx4 v9, v[16:19], s[38:39]
    ds_write_b128 v7, v[16:19] offset:5376
    ds_write_b32 v125, v11 offset:5324
    s_mov_b64 exec, -1
L_w_prep:
    s_mul_i32 s44, s6, 37
    s_lshr_b32 s44, s44, 8
    s_mul_i32 s45, s44, 7
    s_sub_u32 s45, s6, s45
    s_lshl2_add_u32 s46, s5, s44
    s_cmp_ge_u32 s6, 28
    s_cselect_b32 s47, 99, s46
    v_lshrrev_b32 v4, 5, v1
    v_bfe_u32 v5, v1, 4, 1
    v_lshl_add_u32 v39, v5, 1, v4
    v_and_b32 v4, 15, v1
    v_mul_u32_u24 v32, 896, v39
    v_lshl_add_u32 v32, v4, 3, v32
    v_add_u32 v33, 7168, v32
    v_mov_b32 v34, v32
    v_lshl_add_u32 v39, v4, 2, v39
    s_lshl_b32 s3, s45, 7
    s_lshl2_add_u32 s11, s46, s4
    s_mul_i32 s42, s11, 14336
    s_add_u32 s42, s42, s3
    s_add_u32 s40, s32, s42
    s_addc_u32 s41, s33, 0
    s_and_b32 s11, s4, 1
    s_lshl1_add_u32 s11, s46, s11
    s_lshl_b32 s11, s11, 4
    s_lshr_b32 s42, s4, 1
    s_add_u32 s11, s11, s42
    s_add_u32 s11, s11, 1
    s_mul_i32 s42, s11, 3584
    s_add_u32 s42, s42, s3
    s_add_u32 s42, s24, s42
    s_addc_u32 s43, s25, 0
    v_lshrrev_b32 v4, 3, v1
    v_and_b32 v5, 7, v1
    v_lshlrev_b32 v5, 4, v5
    s_lshl_b32 s11, s46, 12
    s_lshl_b32 s3, s4, 7
    s_add_u32 s11, s11, s3
    s_add_u32 s11, s11, 131072
    v_lshl_add_u32 v8, v4, 9, v5
    v_add_u32 v8, s11, v8
    s_mul_i32 s11, s5, 69632
    s_add_u32 s11, s11, s3
    s_lshl_b32 s3, s44, 9
    s_add_u32 s11, s11, s3
    s_add_u32 s11, s11, 264320
    v_mul_u32_u24 v36, 8704, v4
    v_add3_u32 v36, v36, v5, s11
    v_add_u32 v37, 4352, v36
    s_lshl_b32 s11, s5, 9
    s_add_u32 s52, s11, 851968
    v_and_b32 v5, 48, v5
    v_lshl_add_u32 v38, v4, 6, v5
    v_add_u32 v38, s52, v38
    s_lshl_b32 s11, s4, 9
    v_lshl_add_u32 v39, v39, 3, s11
    v_mov_b32 v13, 0
    s_waitcnt lgkmcnt(0)
    s_add_u32 s9, s50, 0x5b
    s_and_b32 s9, s9, 0xff
    v_mov_b32 v6, s9
L_w_kh:
    s_sleep 1
    ds_read_b32 v16, v125 offset:5336
    s_waitcnt lgkmcnt(0)
    v_cmp_gt_u32 vcc, 1, v16
    s_cbranch_vccnz L_w_kh
    s_setprio 2
    s_cmp_lt_u32 s4, 2
    s_cbranch_scc1 L_w_rest
    s_lshl_b32 s11, s5, 13
    s_add_u32 s11, s11, 2048
    v_add_u32 v2, s11, v7
    v_add_u32 v3, 4096, v2
    s_lshl_b32 s10, s6, 8
    s_add_u32 s11, s11, s10
    s_add_u32 s11, s11, 2048
    v_lshlrev_b32 v76, 4, v1
    v_add_u32 v77, s11, v76
    s_getreg_b32 s11, hwreg(HW_REG_XCC_ID, 0, 4)
    v_xor_b32 v10, s11, v6
    s_mov_b32 s10, 0
L_qtry:
    global_load_dwordx4 v[16:19], v2, s[38:39] sc1
    global_load_dwordx4 v[20:23], v2, s[38:39] offset:2048 sc1
    global_load_dwordx4 v[24:27], v3, s[38:39] sc1
    global_load_dwordx4 v[28:31], v3, s[38:39] offset:2048 sc1
    s_cmp_lg_u32 s10, 0
    s_cbranch_scc1 L_q_w0
    s_cmp_ge_u32 s6, 28
    s_cbranch_scc1 L_q_w0
    global_load_dwordx2 v[48:49], v34, s[42:43] offset:-3584 nt
    global_load_dwordx2 v[50:51], v34, s[42:43] offset:3584 nt
    v_add_u32 v34, 14336, v34
    global_load_dwordx2 v[52:53], v34, s[42:43] offset:-3584 nt
    global_load_dwordx2 v[54:55], v34, s[42:43] offset:3584 nt
    v_add_u32 v34, 14336, v34
    global_load_dwordx2 v[56:57], v34, s[42:43] offset:-3584 nt
    global_load_dwordx2 v[58:59], v34, s[42:43] offset:3584 nt
    v_add_u32 v34, 14336, v34
    global_load_dwordx2 v[60:61], v34, s[42:43] offset:-3584 nt
    global_load_dwordx2 v[62:63], v34, s[42:43] offset:3584 nt
    s_waitcnt vmcnt(8)
    s_branch L_q_w1
L_q_w0:
    s_waitcnt vmcnt(0)
L_q_w1:
    s_add_u32 s10, s10, 1
    v_bitop3_b32 v64, v16, v17, v6 bitop3:0x7e
    v_bitop3_b32 v65, v18, v20, v6 bitop3:0x7e
    v_bitop3_b32 v66, v21, v22, v6 bitop3:0x7e
    v_bitop3_b32 v67, v24, v25, v6 bitop3:0x7e
    v_bitop3_b32 v68, v26, v28, v6 bitop3:0x7e
    v_bitop3_b32 v69, v29, v30, v6 bitop3:0x7e
    v_or3_b32 v64, v64, v65, v66
    v_or3_b32 v67, v67, v68, v69
    v_or_b32 v64, v64, v67
    v_bitop3_b32 v72, v19, v23, v10 bitop3:0x7e
    v_bitop3_b32 v73, v27, v31, v10 bitop3:0x7e
    v_or_b32 v72, v72, v73
    v_and_b32 v74, 0xf0, v72
    v_or_b32 v64, v64, v74
    v_cmp_ne_u32_sdwa vcc, v64, v125 src0_sel:BYTE_0 src1_sel:DWORD
    s_cbranch_vccz L_qok
    s_cmp_lg_u32 s10, 3
    s_cbranch_scc1 L_qnorep
    s_mov_b64 exec, 0xffff
    ds_read_b128 v[64:67], v76 offset:5376
    s_waitcnt lgkmcnt(0)
    global_store_dwordx4 v77, v[64:67], s[38:39] sc1
    s_mov_b64 exec, -1
L_qnorep:
    s_cmp_lt_u32 s10, 32768
    s_cbranch_scc1 L_qtry
L_qok:
    v_cmp_ne_u32_sdwa vcc, v72, v125 src0_sel:BYTE_0 src1_sel:DWORD
    v_and_b32 v16, s12, v16
    v_and_b32 v17, s12, v17
    v_and_b32 v18, s12, v18
    v_and_b32 v19, s12, v19
    v_and_b32 v20, s12, v20
    v_and_b32 v21, s12, v21
    v_and_b32 v22, s12, v22
    v_and_b32 v23, s12, v23
    v_and_b32 v24, s12, v24
    v_and_b32 v25, s12, v25
    v_and_b32 v26, s12, v26
    v_and_b32 v27, s12, v27
    v_and_b32 v28, s12, v28
    v_and_b32 v29, s12, v29
    v_and_b32 v30, s12, v30
    v_and_b32 v31, s12, v31
    v_pk_add_f32 v[16:17], v[16:17], v[20:21]
    v_pk_add_f32 v[18:19], v[18:19], v[22:23]
    v_pk_add_f32 v[24:25], v[24:25], v[28:29]
    v_pk_add_f32 v[26:27], v[26:27], v[30:31]
    v_pk_add_f32 v[16:17], v[16:17], v[24:25]
    v_pk_add_f32 v[18:19], v[18:19], v[26:27]
    v_lshlrev_b32 v3, 3, v0
    v_cvt_pk_bf16_f32 v16, v16, v17
    v_cvt_pk_bf16_f32 v17, v18, v19
    v_mov_b32 v11, 1
    ds_write_b64 v3, v[16:17] offset:3072
    s_cbranch_vccz L_qsame
    ds_write_b32 v125, v11 offset:5316
    s_mov_b64 exec, 0xffff
    ds_read_b128 v[64:67], v76 offset:5376
    s_waitcnt lgkmcnt(0)
    global_store_dwordx4 v77, v[64:67], s[38:39] sc1
    s_mov_b64 exec, -1
L_qsame:
    s_mov_b64 exec, 1
    ds_add_u32 v125, v11 offset:5312
    s_mov_b64 exec, -1
    s_cmp_ge_u32 s6, 28
    s_cbranch_scc1 L_w_B2
    s_branch L_w_rest2
L_w_rest:
    s_cmp_ge_u32 s6, 28
    s_cbranch_scc1 L_w_B2
    global_load_dwordx2 v[48:49], v34, s[42:43] offset:-3584 nt
    global_load_dwordx2 v[50:51], v34, s[42:43] offset:3584 nt
    v_add_u32 v34, 14336, v34
    global_load_dwordx2 v[52:53], v34, s[42:43] offset:-3584 nt
    global_load_dwordx2 v[54:55], v34, s[42:43] offset:3584 nt
    v_add_u32 v34, 14336, v34
    global_load_dwordx2 v[56:57], v34, s[42:43] offset:-3584 nt
    global_load_dwordx2 v[58:59], v34, s[42:43] offset:3584 nt
    v_add_u32 v34, 14336, v34
    global_load_dwordx2 v[60:61], v34, s[42:43] offset:-3584 nt
    global_load_dwordx2 v[62:63], v34, s[42:43] offset:3584 nt
L_w_rest2:
    s_cmp_ge_u32 s47, 28
    s_cbranch_scc1 L_w_B2
    global_load_dwordx2 v[40:41], v32, s[40:41] offset:0 nt
    global_load_dwordx2 v[42:43], v32, s[40:41] offset:3584 nt
    global_load_dwordx2 v[44:45], v33, s[40:41] offset:0 nt
    global_load_dwordx2 v[46:47], v33, s[40:41] offset:3584 nt
    global_load_dwordx4 v[96:99], v8, s[38:39] sc1
L_w_B2:
    v_lshrrev_b32 v4, 4, v0
    v_and_b32 v5, 3, v1
    v_lshl_add_u32 v4, v4, 2, v5
    v_and_b32 v5, 4, v1
    v_lshl_add_u32 v7, v4, 3, v5
    s_lshl_b32 s11, s45, 7
    v_lshl_add_u32 v4, v4, 1, s11
    global_load_ushort v9, v4, s[16:17]
    s_mul_i32 s11, s45, 6144
    s_add_u32 s11, s11, 1048576
    v_lshrrev_b32 v2, 4, v0
    v_mul_u32_u24 v2, 384, v2
    v_and_b32 v10, 15, v1
    v_lshl_add_u32 v2, v10, 2, v2
    v_add_u32 v2, s11, v2
    s_mov_b32 s56, 0x00ff00ff
    s_mov_b32 s57, 0x00ff00ff
    s_mov_b32 s58, 0x01ff01ff
    s_mov_b32 s59, 0x01ff01ff
    s_mov_b32 s60, 0x000f000f
    s_mov_b32 s61, 0x000f000f
    v_mov_b32 v14, 1.0
    s_cmp_lt_u32 s4, 2
    s_cbranch_scc1 L_w_norep
    s_branch L_w_q1
L_w_qspin:
    s_sleep 2
L_w_q1:
    ds_read_b64 v[16:17], v125 offset:5312
    s_waitcnt lgkmcnt(0)
    v_cmp_ne_u32 vcc, 2, v16
    s_cbranch_vccnz L_w_qspin
    v_cmp_eq_u32 vcc, 0, v17
    s_cbranch_vccnz L_w_norep
    s_cmp_eq_u32 s5, 7
    s_cbranch_scc1 L_w_norep
    s_mov_b64 exec, 0x00ff00ff
    global_store_dwordx4 v116, v[112:115], s[38:39] sc1
    s_mov_b64 exec, -1
L_w_norep:
    s_bitcmp1_b32 s44, 1
    s_cselect_b64 s[64:65], -1, 0
    s_cmp_ge_u32 s47, 28
    s_cbranch_scc1 L_w_noffn2
    s_movk_i32 s10, 32767
    s_waitcnt vmcnt(0)
L_fchk:
    v_bitop3_b32 v20, v96, v97, v6 bitop3:0x7e
    v_bitop3_b32 v21, v98, v99, v6 bitop3:0x7e
    v_or_b32 v20, v20, v21
    v_cmp_ne_u32_sdwa vcc, v20, v125 src0_sel:BYTE_0 src1_sel:DWORD
    s_cbranch_vccz L_fok
    s_sub_u32 s10, s10, 1
    s_cbranch_scc1 L_fok
    global_load_dwordx4 v[96:99], v8, s[38:39] sc1
    s_waitcnt vmcnt(0)
    s_branch L_fchk
L_fok:
    v_and_b32 v16, s12, v96
    v_and_b32 v17, s12, v97
    v_and_b32 v18, s12, v98
    v_and_b32 v19, s12, v99
    v_perm_b32 v20, v42, v40, s13
    v_perm_b32 v21, v42, v40, s14
    v_permlane32_swap_b32 v18, v19
    v_permlane32_swap_b32 v16, v17
    v_add_f32 v18, v18, v19
    v_add_f32 v16, v16, v17
    v_perm_b32 v22, v43, v41, s13
    v_perm_b32 v23, v43, v41, s14
    v_permlane16_swap_b32 v16, v18
    v_add_f32 v16, v16, v18
    v_perm_b32 v24, v46, v44, s13
    v_perm_b32 v25, v46, v44, s14
    v_add_f32_dpp v16, v16, v16 row_ror:8 row_mask:0xf bank_mask:0xf
    v_cvt_pk_bf16_f32 v16, 0, v16
    v_max_f32 v17, 0, v16
    v_perm_b32 v26, v47, v45, s13
    v_perm_b32 v27, v47, v45, s14
    v_mul_f32_dpp v17, v16, v17 row_ror:4 row_mask:0xf bank_mask:0xf
    v_mov_b64 v[28:29], 0
    v_mov_b64 v[30:31], 0
    v_mov_b32_dpp v18, v17 quad_perm:[1,0,3,2] row_mask:0xf bank_mask:0xf
    v_cvt_pk_bf16_f32 v16, v17, v18
    s_nop 1
    v_dot2c_f32_bf16_dpp v28, v16, v20 row_newbcast:0 row_mask:0xf bank_mask:0xf
    v_dot2c_f32_bf16_dpp v29, v16, v21 row_newbcast:0 row_mask:0xf bank_mask:0xf
    v_dot2c_f32_bf16_dpp v30, v16, v22 row_newbcast:0 row_mask:0xf bank_mask:0xf
    v_dot2c_f32_bf16_dpp v31, v16, v23 row_newbcast:0 row_mask:0xf bank_mask:0xf
    v_dot2c_f32_bf16_dpp v28, v16, v24 row_newbcast:2 row_mask:0xf bank_mask:0xf
    v_dot2c_f32_bf16_dpp v29, v16, v25 row_newbcast:2 row_mask:0xf bank_mask:0xf
    v_dot2c_f32_bf16_dpp v30, v16, v26 row_newbcast:2 row_mask:0xf bank_mask:0xf
    v_dot2c_f32_bf16_dpp v31, v16, v27 row_newbcast:2 row_mask:0xf bank_mask:0xf
    s_nop 2
    v_permlane32_swap_b32 v30, v31
    v_permlane32_swap_b32 v28, v29
    v_add_f32 v30, v30, v31
    v_add_f32 v28, v28, v29
    s_nop 1
    v_permlane16_swap_b32 v28, v30
    v_add_f32 v13, v28, v30
L_w_noffn2:
    s_waitcnt vmcnt(0)
    v_perm_b32 v64, v50, v48, s13
    v_perm_b32 v65, v50, v48, s14
    v_perm_b32 v66, v51, v49, s13
    v_perm_b32 v67, v51, v49, s14
    v_perm_b32 v68, v54, v52, s13
    v_perm_b32 v69, v54, v52, s14
    v_perm_b32 v70, v55, v53, s13
    v_perm_b32 v71, v55, v53, s14
    v_perm_b32 v72, v58, v56, s13
    v_perm_b32 v73, v58, v56, s14
    v_perm_b32 v74, v59, v57, s13
    v_perm_b32 v75, v59, v57, s14
    v_perm_b32 v76, v62, v60, s13
    v_perm_b32 v77, v62, v60, s14
    v_perm_b32 v78, v63, v61, s13
    v_perm_b32 v79, v63, v61, s14
    v_mov_b64 v[44:45], 0
    v_mov_b64 v[46:47], 0
    v_lshlrev_b32 v9, 16, v9
    s_cmp_lg_u32 s4, 1
    s_cbranch_scc1 L_noflag
    s_lshl_b32 s11, s45, 7
    s_add_u32 s11, s11, 917504
    s_mul_i32 s40, s9, 0x01010101
    s_movk_i32 s10, 32767
L_flag:
    s_load_dword s41, s[38:39], s11 glc
    s_sub_u32 s10, s10, 1
    s_cbranch_scc1 L_ml_done
    s_waitcnt lgkmcnt(0)
    s_cmp_lg_u32 s41, s40
    s_cbranch_scc1 L_flag
L_noflag:
L_ml_done:
    s_cmp_ge_u32 s6, 28
    s_cbranch_scc1 L_end
    s_movk_i32 s10, 32767
    s_setprio 0
    s_barrier
    global_load_dwordx4 v[92:95], v38, s[38:39] sc1
    s_barrier
    global_load_dwordx4 v[16:19], v36, s[38:39] offset:-2176 sc1
    global_load_dwordx4 v[20:23], v36, s[38:39] offset:0 sc1
    global_load_dwordx4 v[24:27], v37, s[38:39] offset:-2176 sc1
    global_load_dwordx4 v[28:31], v37, s[38:39] offset:0 sc1
    s_waitcnt vmcnt(4)
    v_bitop3_b32 v88, v92, v93, v6 bitop3:0x7e
    v_bitop3_b32 v89, v94, v95, v6 bitop3:0x7e
    v_or_b32 v88, v88, v89
    v_cmp_ne_u32_sdwa vcc, v88, v125 src0_sel:BYTE_0 src1_sel:DWORD
    s_cbranch_vccnz L_mre
L_mok:
    v_cndmask_b32 v90, v92, v94, s[64:65]
    v_cndmask_b32 v91, v93, v95, s[64:65]
    v_and_b32 v90, s12, v90
    v_and_b32 v91, s12, v91
    s_nop 0
    v_max_f32_dpp v88, v90, v90 quad_perm:[1,0,3,2] row_mask:0xf bank_mask:0xf
    s_nop 1
    v_max_f32_dpp v88, v88, v88 quad_perm:[2,3,0,1] row_mask:0xf bank_mask:0xf
    s_nop 1
    v_max_f32_dpp v88, v88, v88 row_ror:8 row_mask:0xf bank_mask:0xf
    v_mov_b32 v89, v88
    s_nop 1
    v_permlane16_swap_b32 v88, v89
    v_max_f32 v88, v88, v89
    v_mov_b32 v89, v88
    s_nop 1
    v_permlane32_swap_b32 v88, v89
    v_max_f32 v88, v88, v89
    v_sub_f32 v90, v90, v88
    v_mul_f32 v90, 0x3db8aa3b, v90
    v_exp_f32 v90, v90
    s_nop 0
    v_mul_f32 v88, v90, v91
    s_nop 1
    v_add_f32_dpp v88, v88, v88 quad_perm:[1,0,3,2] row_mask:0xf bank_mask:0xf
    s_nop 1
    v_add_f32_dpp v88, v88, v88 quad_perm:[2,3,0,1] row_mask:0xf bank_mask:0xf
    s_nop 1
    v_add_f32_dpp v88, v88, v88 row_ror:8 row_mask:0xf bank_mask:0xf
    v_mov_b32 v89, v88
    s_nop 1
    v_permlane16_swap_b32 v88, v89
    v_add_f32 v88, v88, v89
    v_mov_b32 v89, v88
    s_nop 1
    v_permlane32_swap_b32 v88, v89
    v_add_f32 v88, v88, v89
    v_rcp_f32 v88, v88
    s_nop 0
    v_mul_f32 v90, v88, v90
    s_nop 1
    v_mov_b32_dpp v80, v90 quad_perm:[0,0,0,0] row_mask:0xf bank_mask:0xf
    v_mov_b32_dpp v82, v90 quad_perm:[1,1,1,1] row_mask:0xf bank_mask:0xf
    v_mov_b32_dpp v84, v90 quad_perm:[2,2,2,2] row_mask:0xf bank_mask:0xf
    v_mov_b32_dpp v86, v90 quad_perm:[3,3,3,3] row_mask:0xf bank_mask:0xf
L_ochk:
    s_waitcnt vmcnt(0)
    v_bitop3_b32 v88, v16, v20, v6 bitop3:0x7e
    v_pk_mul_f32 v[42:43], v[18:19], v[80:81] op_sel_hi:[1,0]
    v_bitop3_b32 v89, v24, v28, v6 bitop3:0x7e
    v_pk_fma_f32 v[42:43], v[22:23], v[82:83], v[42:43] op_sel_hi:[1,0,1]
    v_or_b32 v88, v88, v89
    v_pk_fma_f32 v[42:43], v[26:27], v[84:85], v[42:43] op_sel_hi:[1,0,1]
    v_cmp_ne_u32_sdwa vcc, v88, v125 src0_sel:BYTE_0 src1_sel:DWORD
    v_pk_fma_f32 v[42:43], v[30:31], v[86:87], v[42:43] op_sel_hi:[1,0,1]
    s_cbranch_vccnz L_opoll
L_ook:
    v_and_b32 v16, s12, v16
    v_and_b32 v20, s12, v20
    v_pk_mul_f32 v[16:17], v[16:17], v[80:81] op_sel_hi:[1,0]
    v_and_b32 v24, s12, v24
    v_pk_fma_f32 v[16:17], v[20:21], v[82:83], v[16:17] op_sel_hi:[1,0,1]
    v_and_b32 v28, s12, v28
    v_pk_fma_f32 v[16:17], v[24:25], v[84:85], v[16:17] op_sel_hi:[1,0,1]
    v_permlane32_swap_b32 v42, v43
    v_pk_fma_f32 v[16:17], v[28:29], v[86:87], v[16:17] op_sel_hi:[1,0,1]
    v_add_f32 v42, v42, v43
    s_nop 0
    v_permlane32_swap_b32 v16, v17
    v_add_f32 v16, v16, v17
    s_nop 1
    v_permlane16_swap_b32 v16, v42
    v_add_f32 v16, v16, v42
    s_nop 1
    v_add_f32_dpp v16, v16, v16 row_ror:8 row_mask:0xf bank_mask:0xf
    s_nop 1
    v_mov_b32_dpp v17, v16 quad_perm:[1,0,3,2] row_mask:0xf bank_mask:0xf
    v_cvt_pk_bf16_f32 v16, v16, v17
    s_nop 1
    v_dot2c_f32_bf16_dpp v44, v16, v64 row_newbcast:0 row_mask:0xf bank_mask:0xf
    v_dot2c_f32_bf16_dpp v45, v16, v65 row_newbcast:0 row_mask:0xf bank_mask:0xf
    v_dot2c_f32_bf16_dpp v46, v16, v66 row_newbcast:0 row_mask:0xf bank_mask:0xf
    v_dot2c_f32_bf16_dpp v47, v16, v67 row_newbcast:0 row_mask:0xf bank_mask:0xf
    v_dot2c_f32_bf16_dpp v44, v16, v68 row_newbcast:2 row_mask:0xf bank_mask:0xf
    v_dot2c_f32_bf16_dpp v45, v16, v69 row_newbcast:2 row_mask:0xf bank_mask:0xf
    v_dot2c_f32_bf16_dpp v46, v16, v70 row_newbcast:2 row_mask:0xf bank_mask:0xf
    v_dot2c_f32_bf16_dpp v47, v16, v71 row_newbcast:2 row_mask:0xf bank_mask:0xf
    v_dot2c_f32_bf16_dpp v44, v16, v72 row_newbcast:4 row_mask:0xf bank_mask:0xf
    v_dot2c_f32_bf16_dpp v45, v16, v73 row_newbcast:4 row_mask:0xf bank_mask:0xf
    v_dot2c_f32_bf16_dpp v46, v16, v74 row_newbcast:4 row_mask:0xf bank_mask:0xf
    v_dot2c_f32_bf16_dpp v47, v16, v75 row_newbcast:4 row_mask:0xf bank_mask:0xf
    v_dot2c_f32_bf16_dpp v44, v16, v76 row_newbcast:6 row_mask:0xf bank_mask:0xf
    v_dot2c_f32_bf16_dpp v45, v16, v77 row_newbcast:6 row_mask:0xf bank_mask:0xf
    v_dot2c_f32_bf16_dpp v46, v16, v78 row_newbcast:6 row_mask:0xf bank_mask:0xf
    v_dot2c_f32_bf16_dpp v47, v16, v79 row_newbcast:6 row_mask:0xf bank_mask:0xf
    s_nop 2
    v_permlane32_swap_b32 v46, v47
    v_permlane32_swap_b32 v44, v45
    v_add_f32 v46, v46, v47
    v_add_f32 v44, v44, v45
    s_nop 1
    v_permlane16_swap_b32 v44, v46
    v_add_f32 v12, v44, v46
    ds_write_b64 v39, v[12:13] offset:0
    s_mov_b64 exec, s[56:57]
    s_waitcnt lgkmcnt(0)
    s_barrier
    ds_read2st64_b32 v[16:17], v7 offset0:0 offset1:2
    ds_read2st64_b32 v[18:19], v7 offset0:4 offset1:6
    s_waitcnt lgkmcnt(1)
    v_add_f32 v16, v16, v17
    s_waitcnt lgkmcnt(0)
    v_add_f32 v18, v18, v19
    v_add_f32 v14, v16, v18
    s_mov_b64 exec, s[58:59]
    global_atomic_add_f32 v17, v2, v14, s[38:39] sc0 sc1
    s_waitcnt vmcnt(0)
    v_add_f32 v16, v14, v17
    v_cvt_pk_bf16_f32 v18, 0, v16
    v_mul_f32 v17, 0xbfb8aa3b, v18
    v_exp_f32 v17, v17
    v_mov_b32_dpp v19, v16 row_newbcast:8 row_mask:0xf bank_mask:0xf
    v_add_f32 v17, 1.0, v17
    v_rcp_f32 v17, v17
    v_cmp_eq_f32 vcc, 0x42000000, v19
    v_mul_f32 v17, v18, v17
    v_cvt_pk_bf16_f32 v17, 0, v17
    s_and_b64 s[60:61], s[60:61], vcc
    s_cbranch_scc0 L_fin_skip
    v_mul_f32_dpp v16, v17, v18 row_shl:4 row_mask:0xf bank_mask:0xf
    v_cvt_pk_bf16_f32 v16, 0, v16
    s_mov_b64 exec, s[60:61]
    v_add_f32 v16, v9, v16
    v_cvt_pk_bf16_f32 v16, v16, v16
    global_store_short v4, v16, s[34:35]
    v_cmp_eq_u32 vcc, 0, v4
    s_and_b64 exec, exec, vcc
    s_cbranch_execz L_fin_skip
    global_store_dword v4, v6, s[38:39]
L_fin_skip:
    s_endpgm
L_mre:
    s_sub_u32 s10, s10, 1
    s_cbranch_scc1 L_mok
    global_load_dwordx4 v[92:95], v38, s[38:39] sc1
    s_waitcnt vmcnt(0)
    v_bitop3_b32 v88, v92, v93, v6 bitop3:0x7e
    v_bitop3_b32 v89, v94, v95, v6 bitop3:0x7e
    v_or_b32 v88, v88, v89
    v_cmp_ne_u32_sdwa vcc, v88, v125 src0_sel:BYTE_0 src1_sel:DWORD
    s_cbranch_vccnz L_mre
    global_load_dwordx4 v[16:19], v36, s[38:39] offset:-2176 sc1
    global_load_dwordx4 v[20:23], v36, s[38:39] offset:0 sc1
    global_load_dwordx4 v[24:27], v37, s[38:39] offset:-2176 sc1
    global_load_dwordx4 v[28:31], v37, s[38:39] offset:0 sc1
    s_branch L_mok
L_opoll:
    v_cmp_ne_u32_sdwa s[20:21], v16, v6 src0_sel:BYTE_0 src1_sel:DWORD
    v_cmp_ne_u32_sdwa s[22:23], v20, v6 src0_sel:BYTE_0 src1_sel:DWORD
    v_cmp_ne_u32_sdwa s[24:25], v24, v6 src0_sel:BYTE_0 src1_sel:DWORD
    v_cmp_ne_u32_sdwa s[26:27], v28, v6 src0_sel:BYTE_0 src1_sel:DWORD
    s_sub_u32 s10, s10, 1
    s_cbranch_scc1 L_ook
    s_cmp_eq_u64 s[20:21], 0
    s_cbranch_scc1 L_sp0
    global_load_dwordx4 v[16:19], v36, s[38:39] offset:-2176 sc1
L_sp0:
    s_cmp_eq_u64 s[22:23], 0
    s_cbranch_scc1 L_sp1
    global_load_dwordx4 v[20:23], v36, s[38:39] offset:0 sc1
L_sp1:
    s_cmp_eq_u64 s[24:25], 0
    s_cbranch_scc1 L_sp2
    global_load_dwordx4 v[24:27], v37, s[38:39] offset:-2176 sc1
L_sp2:
    s_cmp_eq_u64 s[26:27], 0
    s_cbranch_scc1 L_ochk
    global_load_dwordx4 v[28:31], v37, s[38:39] offset:0 sc1
    s_branch L_ochk
L_A:
    v_mov_b32 v125, 0
    s_mov_b32 s13, 0x05040100
    s_mov_b32 s14, 0x07060302
    s_mov_b32 s12, 0xffffff00
    s_mov_b32 s15, 0xffff0000
    s_lshl_b32 s11, s5, 25
    s_lshl_b32 s42, s6, 13
    s_add_u32 s11, s11, s42
    s_add_u32 s11, s11, 31457280
    s_and_b32 s7, s4, 3
    v_lshrrev_b32 v3, 4, v1
    v_bfe_u32 v7, v1, 3, 1
    v_mov_b32 v12, 1
    s_barrier
    s_waitcnt lgkmcnt(0)
    s_load_dword s50, s[38:39], 0
    s_cmp_lt_u32 s4, 8
    s_cbranch_scc1 L_K
    s_setprio 1
    s_add_u32 s42, s20, s11
    s_addc_u32 s43, s21, 0
    v_and_b32 v2, 15, v1
    v_lshlrev_b32 v5, 11, v3
    v_lshl_add_u32 v5, v2, 4, v5
    s_and_b32 s46, s7, 1
    s_lshr_b32 s47, s7, 1
    s_lshl_b32 s11, s46, 8
    s_lshl_b32 s10, s47, 20
    s_add_u32 s11, s11, s10
    v_add_u32 v5, s11, v5
    s_lshl_b32 s8, s5, 5
    s_add_u32 s8, s8, s6
    s_mul_i32 s8, s8, 2176
    s_lshl_b32 s11, s46, 9
    s_add_u32 s11, s11, s8
    s_add_u32 s11, s11, 262144
    v_lshrrev_b32 v13, 5, v1
    v_lshlrev_b32 v13, 10, v13
    v_and_b32 v14, 31, v1
    v_lshl_add_u32 v13, v14, 4, v13
    v_add_u32 v14, s11, v13
    v_lshlrev_b32 v13, 8, v7
    v_lshl_add_u32 v13, v3, 6, v13
    s_lshl_b32 s11, s47, 5
    v_add_u32 v13, s11, v13
    s_lshl_b32 s11, s46, 10
    v_lshl_add_u32 v152, v1, 4, s11
    s_lshl_b32 s11, s46, 2
    v_mov_b32 v153, s11
    v_mov_b32 v154, 0
    s_mov_b32 s48, 0x01010101
    s_mov_b32 s49, 0x01010101
    s_barrier
    v_mov_b64 v[80:81], 0
    v_mov_b64 v[82:83], 0
    v_mov_b64 v[84:85], 0
    v_mov_b64 v[86:87], 0
    v_mov_b64 v[88:89], 0
    v_mov_b64 v[90:91], 0
    v_mov_b64 v[92:93], 0
    v_mov_b64 v[94:95], 0
    v_mov_b64 v[96:97], 0
    v_mov_b64 v[98:99], 0
    v_mov_b64 v[100:101], 0
    v_mov_b64 v[102:103], 0
    v_mov_b64 v[104:105], 0
    v_mov_b64 v[106:107], 0
    v_mov_b64 v[108:109], 0
    v_mov_b64 v[110:111], 0
    v_mov_b64 v[112:113], 0
    v_mov_b64 v[114:115], 0
    v_mov_b64 v[116:117], 0
    v_mov_b64 v[118:119], 0
    v_mov_b64 v[120:121], 0
    v_mov_b64 v[122:123], 0
    v_mov_b64 v[124:125], 0
    v_mov_b64 v[126:127], 0
    v_mov_b64 v[128:129], 0
    v_mov_b64 v[130:131], 0
    v_mov_b64 v[132:133], 0
    v_mov_b64 v[134:135], 0
    v_mov_b64 v[136:137], 0
    v_mov_b64 v[138:139], 0
    v_mov_b64 v[140:141], 0
    v_mov_b64 v[142:143], 0
    s_cmp_eq_u32 s47, 0
    s_cselect_b32 s10, 5336, 0
    s_cselect_b32 s11, 4, 2
    s_cbranch_scc1 L_v_k0
    s_movk_i32 s10, 5340
L_v_k0:
    v_mov_b32 v155, s10
L_v_kh:
    s_sleep 1
    ds_read_b32 v4, v155
    s_waitcnt lgkmcnt(0)
    v_cmp_gt_u32 vcc, s11, v4
    s_cbranch_vccnz L_v_kh
    s_add_u32 s9, s50, 0x5b
    s_and_b32 s9, s9, 0xff
    v_mov_b32 v15, s9
    v_not_b32 v156, v15
    v_mov_b32 v157, 0
    v_mov_b64 v[158:159], 0
    s_cmp_eq_u32 s47, 0
    s_cbranch_scc1 L_v_noinv
    global_store_dwordx4 v14, v[156:159], s[38:39]
L_v_noinv:
    global_load_dwordx4 v[16:19], v5, s[42:43] offset:0 nt
    global_load_dwordx4 v[20:23], v5, s[42:43] offset:512 nt
    global_load_dwordx4 v[24:27], v5, s[42:43] offset:1024 nt
    global_load_dwordx4 v[28:31], v5, s[42:43] offset:1536 nt
    v_add_u32 v5, 0x40000, v5
    global_load_dwordx4 v[32:35], v5, s[42:43] offset:0 nt
    global_load_dwordx4 v[36:39], v5, s[42:43] offset:512 nt
    global_load_dwordx4 v[40:43], v5, s[42:43] offset:1024 nt
    global_load_dwordx4 v[44:47], v5, s[42:43] offset:1536 nt
    v_add_u32 v5, 0x40000, v5
    global_load_dwordx4 v[48:51], v5, s[42:43] offset:0 nt
    global_load_dwordx4 v[52:55], v5, s[42:43] offset:512 nt
    global_load_dwordx4 v[56:59], v5, s[42:43] offset:1024 nt
    global_load_dwordx4 v[60:63], v5, s[42:43] offset:1536 nt
    v_add_u32 v5, 0x40000, v5
    global_load_dwordx4 v[64:67], v5, s[42:43] offset:0 nt
    global_load_dwordx4 v[68:71], v5, s[42:43] offset:512 nt
    s_mov_b64 exec, 1
    ds_add_u32 v154, v12 offset:5340
    s_mov_b64 exec, -1
    global_load_dwordx4 v[72:75], v5, s[42:43] offset:1024 nt
    global_load_dwordx4 v[76:79], v5, s[42:43] offset:1536 nt
    s_branch L_v_p1
L_v_ps:
    s_sleep 1
L_v_p1:
    ds_read_b32 v4, v154 offset:5332
    ds_read_b128 v[144:147], v13 offset:5632
    ds_read_b128 v[148:151], v13 offset:5648
    ds_read_b32 v5, v154 offset:5316
    s_waitcnt lgkmcnt(3)
    v_cmp_ne_u32 vcc, 4, v4
    s_waitcnt lgkmcnt(0)
    s_cbranch_vccnz L_v_ps
    s_setprio 3
    v_readfirstlane_b32 s3, v5
    s_lshl_b64 exec, s[48:49], 0
    v_mov_b32 v80, v144
    v_mov_b32 v88, v145
    v_mov_b32 v96, v146
    v_mov_b32 v104, v147
    v_mov_b32 v112, v148
    v_mov_b32 v120, v149
    v_mov_b32 v128, v150
    v_mov_b32 v136, v151
    s_lshl_b64 exec, s[48:49], 1
    v_mov_b32 v81, v144
    v_mov_b32 v89, v145
    v_mov_b32 v97, v146
    v_mov_b32 v105, v147
    v_mov_b32 v113, v148
    v_mov_b32 v121, v149
    v_mov_b32 v129, v150
    v_mov_b32 v137, v151
    s_lshl_b64 exec, s[48:49], 2
    v_mov_b32 v82, v144
    v_mov_b32 v90, v145
    v_mov_b32 v98, v146
    v_mov_b32 v106, v147
    v_mov_b32 v114, v148
    v_mov_b32 v122, v149
    v_mov_b32 v130, v150
    v_mov_b32 v138, v151
    s_lshl_b64 exec, s[48:49], 3
    v_mov_b32 v83, v144
    v_mov_b32 v91, v145
    v_mov_b32 v99, v146
    v_mov_b32 v107, v147
    v_mov_b32 v115, v148
    v_mov_b32 v123, v149
    v_mov_b32 v131, v150
    v_mov_b32 v139, v151
    s_lshl_b64 exec, s[48:49], 4
    v_mov_b32 v84, v144
    v_mov_b32 v92, v145
    v_mov_b32 v100, v146
    v_mov_b32 v108, v147
    v_mov_b32 v116, v148
    v_mov_b32 v124, v149
    v_mov_b32 v132, v150
    v_mov_b32 v140, v151
    s_lshl_b64 exec, s[48:49], 5
    v_mov_b32 v85, v144
    v_mov_b32 v93, v145
    v_mov_b32 v101, v146
    v_mov_b32 v109, v147
    v_mov_b32 v117, v148
    v_mov_b32 v125, v149
    v_mov_b32 v133, v150
    v_mov_b32 v141, v151
    s_lshl_b64 exec, s[48:49], 6
    v_mov_b32 v86, v144
    v_mov_b32 v94, v145
    v_mov_b32 v102, v146
    v_mov_b32 v110, v147
    v_mov_b32 v118, v148
    v_mov_b32 v126, v149
    v_mov_b32 v134, v150
    v_mov_b32 v142, v151
    s_lshl_b64 exec, s[48:49], 7
    v_mov_b32 v87, v144
    v_mov_b32 v95, v145
    v_mov_b32 v103, v146
    v_mov_b32 v111, v147
    v_mov_b32 v119, v148
    v_mov_b32 v127, v149
    v_mov_b32 v135, v150
    v_mov_b32 v143, v151
    s_mov_b64 exec, -1
    s_waitcnt vmcnt(14)
    v_perm_b32 v144, v20, v16, s13
    v_perm_b32 v145, v20, v16, s14
    v_perm_b32 v146, v21, v17, s13
    v_perm_b32 v147, v21, v17, s14
    v_perm_b32 v148, v22, v18, s13
    v_perm_b32 v149, v22, v18, s14
    v_mfma_f32_16x16x32_bf16 v[4:7], v[80:83], v[144:147], 0
    v_perm_b32 v150, v23, v19, s13
    v_perm_b32 v151, v23, v19, s14
    s_nop 1
    v_mfma_f32_16x16x32_bf16 v[4:7], v[84:87], v[148:151], v[4:7]
    s_waitcnt vmcnt(12)
    v_perm_b32 v144, v28, v24, s13
    v_perm_b32 v145, v28, v24, s14
    v_perm_b32 v146, v29, v25, s13
    v_perm_b32 v147, v29, v25, s14
    v_perm_b32 v148, v30, v26, s13
    v_perm_b32 v149, v30, v26, s14
    v_mfma_f32_16x16x32_bf16 v[4:7], v[88:91], v[144:147], v[4:7]
    v_perm_b32 v150, v31, v27, s13
    v_perm_b32 v151, v31, v27, s14
    s_nop 1
    v_mfma_f32_16x16x32_bf16 v[4:7], v[92:95], v[148:151], v[4:7]
    s_waitcnt vmcnt(10)
    v_perm_b32 v144, v36, v32, s13
    v_perm_b32 v145, v36, v32, s14
    v_perm_b32 v146, v37, v33, s13
    v_perm_b32 v147, v37, v33, s14
    v_perm_b32 v148, v38, v34, s13
    v_perm_b32 v149, v38, v34, s14
    v_mfma_f32_16x16x32_bf16 v[4:7], v[96:99], v[144:147], v[4:7]
    v_perm_b32 v150, v39, v35, s13
    v_perm_b32 v151, v39, v35, s14
    s_nop 1
    v_mfma_f32_16x16x32_bf16 v[4:7], v[100:103], v[148:151], v[4:7]
    s_waitcnt vmcnt(8)
    v_perm_b32 v144, v44, v40, s13
    v_perm_b32 v145, v44, v40, s14
    v_perm_b32 v146, v45, v41, s13
    v_perm_b32 v147, v45, v41, s14
    v_perm_b32 v148, v46, v42, s13
    v_perm_b32 v149, v46, v42, s14
    v_mfma_f32_16x16x32_bf16 v[4:7], v[104:107], v[144:147], v[4:7]
    v_perm_b32 v150, v47, v43, s13
    v_perm_b32 v151, v47, v43, s14
    s_nop 1
    v_mfma_f32_16x16x32_bf16 v[4:7], v[108:111], v[148:151], v[4:7]
    s_waitcnt vmcnt(6)
    v_perm_b32 v144, v52, v48, s13
    v_perm_b32 v145, v52, v48, s14
    v_perm_b32 v146, v53, v49, s13
    v_perm_b32 v147, v53, v49, s14
    v_perm_b32 v148, v54, v50, s13
    v_perm_b32 v149, v54, v50, s14
    v_mfma_f32_16x16x32_bf16 v[4:7], v[112:115], v[144:147], v[4:7]
    v_perm_b32 v150, v55, v51, s13
    v_perm_b32 v151, v55, v51, s14
    s_nop 1
    v_mfma_f32_16x16x32_bf16 v[4:7], v[116:119], v[148:151], v[4:7]
    s_cmp_eq_u32 s47, 0
    s_cbranch_scc1 L_v_nodep
L_v_dep:
    ds_read_b32 v13, v153 offset:5344
    ds_read_b128 v[8:11], v152 offset:6144
    s_waitcnt lgkmcnt(1)
    v_cmp_eq_u32 vcc, 0, v13
    s_waitcnt lgkmcnt(0)
    s_cbranch_vccnz L_v_dep
    v_pk_add_f32 v[4:5], v[4:5], v[8:9]
    v_pk_add_f32 v[6:7], v[6:7], v[10:11]
    s_barrier
L_v_nodep:
    s_cmp_lg_u32 s3, 0
    s_waitcnt vmcnt(4)
    v_perm_b32 v144, v60, v56, s13
    v_perm_b32 v145, v60, v56, s14
    v_perm_b32 v146, v61, v57, s13
    v_perm_b32 v147, v61, v57, s14
    v_perm_b32 v148, v62, v58, s13
    v_perm_b32 v149, v62, v58, s14
    v_mfma_f32_16x16x32_bf16 v[4:7], v[120:123], v[144:147], v[4:7]
    v_perm_b32 v150, v63, v59, s13
    v_perm_b32 v151, v63, v59, s14
    s_nop 1
    v_mfma_f32_16x16x32_bf16 v[4:7], v[124:127], v[148:151], v[4:7]
    s_waitcnt vmcnt(2)
    v_perm_b32 v144, v68, v64, s13
    v_perm_b32 v145, v68, v64, s14
    v_perm_b32 v146, v69, v65, s13
    v_perm_b32 v147, v69, v65, s14
    v_perm_b32 v148, v70, v66, s13
    v_perm_b32 v149, v70, v66, s14
    v_mfma_f32_16x16x32_bf16 v[4:7], v[128:131], v[144:147], v[4:7]
    v_perm_b32 v150, v71, v67, s13
    v_perm_b32 v151, v71, v67, s14
    s_nop 1
    v_mfma_f32_16x16x32_bf16 v[4:7], v[132:135], v[148:151], v[4:7]
    s_waitcnt vmcnt(0)
    v_perm_b32 v144, v76, v72, s13
    v_perm_b32 v145, v76, v72, s14
    v_perm_b32 v146, v77, v73, s13
    v_perm_b32 v147, v77, v73, s14
    v_perm_b32 v148, v78, v74, s13
    v_perm_b32 v149, v78, v74, s14
    v_mfma_f32_16x16x32_bf16 v[4:7], v[136:139], v[144:147], v[4:7]
    v_perm_b32 v150, v79, v75, s13
    v_perm_b32 v151, v79, v75, s14
    s_nop 1
    v_mfma_f32_16x16x32_bf16 v[4:7], v[140:143], v[148:151], v[4:7]
    s_cbranch_scc1 L_a_slow
    s_cmp_eq_u32 s47, 0
    s_cbranch_scc1 L_v_deposit
    s_nop 4
    v_bfi_b32 v4, s12, v4, v15
    global_store_dwordx4 v14, v[4:7], s[38:39]
    s_barrier
    s_endpgm
L_a_slow:
    s_cmp_eq_u32 s47, 0
    s_cbranch_scc1 L_v_deposit
    global_store_dwordx4 v14, v[156:159], s[38:39] sc1
    s_waitcnt vmcnt(0)
    s_nop 7
    v_bfi_b32 v4, s12, v4, v15
    global_store_dwordx4 v14, v[4:7], s[38:39] sc1
    s_barrier
    s_endpgm
L_v_deposit:
    s_nop 7
    ds_write_b128 v152, v[4:7] offset:6144
    ds_write_b32 v153, v12 offset:5344
    s_endpgm
L_K:
    s_setprio 2
    s_add_u32 s40, s18, s11
    s_addc_u32 s41, s19, 0
    v_and_b32 v2, 15, v1
    v_lshlrev_b32 v4, 9, v2
    v_lshl_add_u32 v4, v3, 4, v4
    s_lshl_b32 s11, s7, 18
    v_add_u32 v4, s11, v4
    v_add_u32 v5, 0x100000, v4
    v_lshlrev_b32 v8, 9, v7
    v_lshl_add_u32 v8, v3, 4, v8
    v_lshlrev_b32 v9, 4, v7
    s_lshl_b32 s11, s7, 2
    v_add_u32 v10, s11, v9
    v_lshlrev_b32 v11, 8, v7
    v_lshl_add_u32 v11, v3, 6, v11
    s_lshl_b32 s11, s7, 3
    v_add_u32 v11, s11, v11
    s_cmp_lt_u32 s7, 4
    s_barrier
    s_cbranch_scc1 L_a_pd0
L_a_ps0:
    ds_read_b32 v120, v125 offset:5324
    s_waitcnt lgkmcnt(0)
    v_cmp_eq_u32 vcc, 0, v120
    s_cbranch_vccz L_a_pd0
    s_sleep 1
    s_branch L_a_ps0
L_a_pd0:
    global_load_dwordx4 v[16:19], v4, s[40:41] offset:0
    global_load_dwordx4 v[20:23], v4, s[40:41] offset:64
    global_load_dwordx4 v[24:27], v4, s[40:41] offset:128
    global_load_dwordx4 v[28:31], v4, s[40:41] offset:192
    global_load_dwordx4 v[32:35], v4, s[40:41] offset:256
    global_load_dwordx4 v[36:39], v4, s[40:41] offset:320
    global_load_dwordx4 v[40:43], v4, s[40:41] offset:384
    global_load_dwordx4 v[44:47], v4, s[40:41] offset:448
L_a_ps1:
    ds_read_b32 v120, v125 offset:5324
    s_waitcnt lgkmcnt(0)
    v_cmp_eq_u32 vcc, 0, v120
    s_cbranch_vccz L_a_pd1
    s_sleep 1
    s_branch L_a_ps1
L_a_pd1:
    global_load_dwordx4 v[48:51], v5, s[40:41] offset:0
    s_mov_b64 exec, 1
    ds_add_u32 v125, v12 offset:5336
    s_mov_b64 exec, -1
    global_load_dwordx4 v[52:55], v5, s[40:41] offset:64
    global_load_dwordx4 v[56:59], v5, s[40:41] offset:128
    global_load_dwordx4 v[60:63], v5, s[40:41] offset:192
    global_load_dwordx4 v[64:67], v5, s[40:41] offset:256
    global_load_dwordx4 v[68:71], v5, s[40:41] offset:320
    global_load_dwordx4 v[72:75], v5, s[40:41] offset:384
    global_load_dwordx4 v[76:79], v5, s[40:41] offset:448
    s_add_u32 s9, s50, 0x5b
    s_and_b32 s9, s9, 0xff
    v_mov_b32 v6, s9
    s_lshl_b32 s11, s5, 9
    s_lshl4_add_u32 s11, s6, s11
    s_add_u32 s11, s11, 851968
    v_mov_b32 v13, s11
    s_setprio 0
    s_branch L_a_q1
L_a_qspin:
    s_sleep 1
L_a_q1:
    ds_read_b64 v[120:121], v125 offset:5312
    s_waitcnt lgkmcnt(0)
    v_cmp_ne_u32 vcc, 2, v120
    s_cbranch_vccnz L_a_qspin
    s_setprio 3
    ds_read_b128 v[80:83], v8 offset:4096
    ds_read_b128 v[84:87], v8 offset:4160
    ds_read_b128 v[88:91], v8 offset:4224
    ds_read_b128 v[92:95], v8 offset:4288
    ds_read_b128 v[96:99], v8 offset:4352
    ds_read_b128 v[100:103], v8 offset:4416
    ds_read_b128 v[104:107], v8 offset:4480
    ds_read_b128 v[108:111], v8 offset:4544
    v_readfirstlane_b32 s3, v121
    s_mov_b32 s11, 0x3db8aa3b
    s_waitcnt vmcnt(8)
    s_waitcnt lgkmcnt(7)
    v_mfma_f32_16x16x32_bf16 v[112:115], v[16:19], v[80:83], 0
    s_waitcnt lgkmcnt(6)
    v_mfma_f32_16x16x32_bf16 v[112:115], v[20:23], v[84:87], v[112:115]
    s_waitcnt lgkmcnt(5)
    v_mfma_f32_16x16x32_bf16 v[112:115], v[24:27], v[88:91], v[112:115]
    s_waitcnt lgkmcnt(4)
    v_mfma_f32_16x16x32_bf16 v[112:115], v[28:31], v[92:95], v[112:115]
    s_waitcnt lgkmcnt(3)
    v_mfma_f32_16x16x32_bf16 v[112:115], v[32:35], v[96:99], v[112:115]
    s_waitcnt lgkmcnt(2)
    v_mfma_f32_16x16x32_bf16 v[112:115], v[36:39], v[100:103], v[112:115]
    s_waitcnt lgkmcnt(1)
    v_mfma_f32_16x16x32_bf16 v[112:115], v[40:43], v[104:107], v[112:115]
    s_waitcnt lgkmcnt(0)
    v_mfma_f32_16x16x32_bf16 v[112:115], v[44:47], v[108:111], v[112:115]
    s_waitcnt vmcnt(0)
    v_mfma_f32_16x16x32_bf16 v[116:119], v[48:51], v[80:83], 0
    v_mfma_f32_16x16x32_bf16 v[116:119], v[52:55], v[84:87], v[116:119]
    v_mfma_f32_16x16x32_bf16 v[116:119], v[56:59], v[88:91], v[116:119]
    v_mfma_f32_16x16x32_bf16 v[116:119], v[60:63], v[92:95], v[116:119]
    v_mfma_f32_16x16x32_bf16 v[116:119], v[64:67], v[96:99], v[116:119]
    v_mfma_f32_16x16x32_bf16 v[116:119], v[68:71], v[100:103], v[116:119]
    v_mfma_f32_16x16x32_bf16 v[116:119], v[72:75], v[104:107], v[116:119]
    v_mfma_f32_16x16x32_bf16 v[116:119], v[76:79], v[108:111], v[116:119]
    v_cvt_pk_bf16_f32 v112, 0, v112
    v_cvt_pk_bf16_f32 v113, 0, v113
    v_cvt_pk_bf16_f32 v114, 0, v114
    v_cvt_pk_bf16_f32 v115, 0, v115
    v_max_f32 v16, v112, v113
    v_max3_f32 v16, v114, v115, v16
    s_nop 1
    v_cvt_pk_bf16_f32 v116, 0, v116
    v_cvt_pk_bf16_f32 v117, 0, v117
    v_cvt_pk_bf16_f32 v118, 0, v118
    v_cvt_pk_bf16_f32 v119, 0, v119
    v_max3_f32 v16, v116, v117, v16
    v_max3_f32 v16, v118, v119, v16
    v_mov_b32 v17, v16
    s_nop 1
    v_permlane16_swap_b32 v16, v17
    v_max_f32 v16, v16, v17
    v_mov_b32 v17, v16
    s_nop 1
    v_permlane32_swap_b32 v16, v17
    v_max_f32 v16, v16, v17
    ds_write_b32 v10, v16 offset:5120
    s_mov_b64 exec, 1
    ds_add_u32 v125, v12 offset:5328
    s_mov_b64 exec, -1
L_k_ms:
    ds_read_b32 v120, v125 offset:5328
    ds_read_b128 v[20:23], v9 offset:5120
    s_waitcnt lgkmcnt(1)
    v_cmp_ne_u32 vcc, 4, v120
    s_waitcnt lgkmcnt(0)
    s_cbranch_vccnz L_k_ms
    v_max_f32 v16, v20, v21
    v_max3_f32 v16, v22, v23, v16
    v_sub_f32 v112, v112, v16
    v_sub_f32 v113, v113, v16
    v_sub_f32 v114, v114, v16
    v_sub_f32 v115, v115, v16
    v_sub_f32 v116, v116, v16
    v_sub_f32 v117, v117, v16
    v_sub_f32 v118, v118, v16
    v_sub_f32 v119, v119, v16
    v_mul_f32 v112, s11, v112
    v_mul_f32 v113, s11, v113
    v_mul_f32 v114, s11, v114
    v_mul_f32 v115, s11, v115
    v_mul_f32 v116, s11, v116
    v_mul_f32 v117, s11, v117
    v_mul_f32 v118, s11, v118
    v_mul_f32 v119, s11, v119
    v_exp_f32 v112, v112
    v_exp_f32 v113, v113
    v_exp_f32 v114, v114
    v_exp_f32 v115, v115
    v_exp_f32 v116, v116
    v_exp_f32 v117, v117
    v_exp_f32 v118, v118
    v_exp_f32 v119, v119
    v_pk_add_f32 v[20:21], v[112:113], v[114:115]
    v_pk_add_f32 v[22:23], v[116:117], v[118:119]
    v_cvt_pk_bf16_f32 v24, v112, v113
    v_cvt_pk_bf16_f32 v25, v114, v115
    v_cvt_pk_bf16_f32 v26, v116, v117
    v_cvt_pk_bf16_f32 v27, v118, v119
    v_pk_add_f32 v[20:21], v[20:21], v[22:23]
    ds_write_b64 v11, v[24:25] offset:5632
    ds_write_b64 v11, v[26:27] offset:5664
    v_add_f32 v17, v20, v21
    v_mov_b32 v18, v17
    s_nop 1
    v_permlane16_swap_b32 v17, v18
    v_add_f32 v17, v17, v18
    v_mov_b32 v18, v17
    s_nop 1
    v_permlane32_swap_b32 v17, v18
    v_add_f32 v17, v17, v18
    ds_write_b32 v10, v17 offset:5184
    s_mov_b64 exec, 1
    ds_add_u32 v125, v12 offset:5332
    s_mov_b64 exec, -1
    s_cmp_lg_u32 s7, 0
    s_cbranch_scc1 L_end
L_k_ls:
    ds_read_b32 v120, v125 offset:5332
    ds_read_b128 v[20:23], v9 offset:5184
    s_waitcnt lgkmcnt(1)
    v_cmp_ne_u32 vcc, 4, v120
    s_waitcnt lgkmcnt(0)
    s_cbranch_vccnz L_k_ls
    v_pk_add_f32 v[20:21], v[20:21], v[22:23]
    v_bfi_b32 v16, s12, v16, v6
    v_add_f32 v17, v20, v21
    v_bfi_b32 v17, s12, v17, v6
    v_mov_b32_dpp v18, v16 row_ror:8 row_mask:0xf bank_mask:0xf
    s_nop 0
    v_mov_b32_dpp v19, v17 row_ror:8 row_mask:0xf bank_mask:0xf
    s_mov_b64 exec, 1
    s_setprio 3
    s_cmp_lg_u32 s3, 0
    s_cbranch_scc1 L_ml_slow
    global_store_dwordx4 v13, v[16:19], s[38:39]
    s_barrier
    s_barrier
    s_endpgm
L_ml_slow:
    global_store_dwordx4 v13, v[16:19], s[38:39] sc1
L_end:
    s_endpgm
.section .rodata,"a"
.p2align 6
.amdhsa_kernel recurrent_scan__sliding_block_cached__glu_gated_reglu__decode_kernel
  .amdhsa_next_free_vgpr 160
  .amdhsa_next_free_sgpr 80
  .amdhsa_accum_offset 160
  .amdhsa_group_segment_fixed_size 0
  .amdhsa_kernarg_size 96
  .amdhsa_user_sgpr_count 2
  .amdhsa_user_sgpr_kernarg_segment_ptr 1
  .amdhsa_system_sgpr_workgroup_id_x 1
.end_amdhsa_kernel
```
